```python
import torch

def _softmax(x, axis=-1):
    return torch.softmax(x, dim=axis)
def _gelu(x):
    return torch.nn.functional.gelu(x, approximate="tanh")
def _silu(x):
    return torch.nn.functional.silu(x)
def _sigmoid(x):
    return torch.sigmoid(x)
def _layernorm(x, axis=-1, eps=1e-5):
    m = x.mean(dim=axis, keepdim=True)
    v = x.var(dim=axis, keepdim=True, unbiased=False)
    return (x - m) / torch.sqrt(v + eps)
def _scatter_add(tgt, idx, src, axis=0):
    return tgt.clone().index_add_(axis, idx, src)
def _segment_sum(src, seg, n):
    out = torch.zeros((n,) + src.shape[1:], dtype=src.dtype)
    return out.index_add_(0, seg, src)
def _pad(x, pw):
    flat = tuple(v for pair in reversed(pw) for v in pair)
    return torch.nn.functional.pad(x, flat)

kernel_name = 'standalone__moe_arch_mod__decode'

def setup_inputs():

    _w = (lambda a: (lambda t: t.to(torch.bfloat16) if t.is_floating_point() else t)(torch.as_tensor(a)))
    B, S, D, F, C = 8, 1, 1024, 3584, 1
    return {
        "x": _w((lambda *s: torch.randn(*s, dtype=torch.bfloat16) * 0.2)(B, S, D)),
        "w_r": _w((lambda *s: torch.randn(*s, dtype=torch.bfloat16) * 0.2)(D)),
        "w_gate": _w((lambda *s: torch.randn(*s, dtype=torch.bfloat16) * 0.1)(D, F)),
        "w_up": _w((lambda *s: torch.randn(*s, dtype=torch.bfloat16) * 0.1)(D, F)),
        "w_down": _w((lambda *s: torch.randn(*s, dtype=torch.bfloat16) * 0.1)(F, D)),
    }

def reference(x, w_r, w_gate, w_up, w_down):
    B, S, D = x.shape
    C = 1
    r = x @ w_r
    idx = torch.argsort(-r, axis=-1)[:, :C]
    idx_e = (lambda x, n, axis: torch.repeat_interleave(x, n, dim=axis))(idx.reshape(B, C, 1), D, axis=2)
    x_sel = (lambda x, i, axis: torch.take_along_dim(x, i, dim=axis))(x, idx_e, axis=1)
    g = _silu(x_sel @ w_gate)
    u = x_sel @ w_up
    y = (g * u) @ w_down
    r_sel = _sigmoid((lambda x, i, axis: torch.take_along_dim(x, i, dim=axis))(r, idx, axis=1))
    y = y * r_sel.reshape(B, C, 1)
    b_off = (torch.arange(B) * S).reshape(B, 1)
    flat_idx = (idx + b_off).reshape(B * C)
    zero = (x * 0.0).reshape(B * S, D)
    upd = _scatter_add(zero, flat_idx, y.reshape(B * C, D), axis=0)
    return x + upd.reshape(B, S, D)
```

```asm
; @launch grid=(256,1,1) block=(256,1,1) lds=108800
.amdgcn_target "amdgcn-amd-amdhsa--gfx950"
.text
.globl standalone__moe_arch_mod__decode_kernel
.p2align 8
.type standalone__moe_arch_mod__decode_kernel,@function
standalone__moe_arch_mod__decode_kernel:
    s_and_b32 s40, s2, 8
    s_add_u32 s40, s40, 16
    s_load_dwordx2 s[4:5], s[0:1], s40
    s_load_dwordx2 s[12:13], s[0:1], 0
    s_load_dwordx2 s[16:17], s[0:1], 56
    s_load_dwordx2 s[8:9], s[0:1], 32
    s_load_dwordx2 s[20:21], s[0:1], 40
    s_cmp_ge_u32 s2, 256
    s_cbranch_scc1 L_end
    s_getpc_b64 s[64:65]
L_pc:
    v_cmp_gt_u32 vcc, (L_codeend-L_pc)/128, v0
    s_and_saveexec_b64 s[62:63], vcc
    s_cbranch_execz L_nocpf
    v_lshlrev_b32 v2, 7, v0
    global_load_dword v151, v2, s[64:65] offset:124
L_nocpf:
    s_mov_b64 exec, s[62:63]
    v_lshrrev_b32 v17, 6, v0
    v_and_b32 v1, 63, v0
    v_readfirstlane_b32 s39, v17
    s_and_b32 s50, s2, 7
    s_lshr_b32 s51, s2, 3
    s_lshr_b32 s59, s2, 5
    s_mov_b32 s6, 7340032
    s_mov_b32 s7, 0x20000
    s_mov_b32 s14, 16384
    s_mov_b32 s15, 0x20000
    s_mov_b32 s18, 4194304
    s_mov_b32 s19, 0x20000
    v_lshlrev_b32 v11, 4, v1
    s_cmp_eq_u32 s50, 7
    s_cbranch_scc1 L_x7
    s_cmp_lt_u32 s59, 5
    s_subb_u32 s59, s59, 1
    s_cmp_lt_u32 s51, 8
    s_cselect_b32 s59, 3, s59
    s_cselect_b32 s38, 1, 0
    s_lshl3_add_u32 s36, s50, s59
    s_branch L_dec
L_x7:
    s_cmp_lt_u32 s51, 4
    s_cbranch_scc1 L_router
    s_lshl3_add_u32 s36, s59, -1
    s_mov_b32 s38, 0
L_dec:
    s_lshl2_add_u32 s40, s38, 3
    s_and_b32 s37, s51, s40
    s_lshr_b32 s47, s37, 1
    s_or_b32 s40, s37, 1
    s_cmp_lg_u32 s38, 0
    s_cselect_b32 s45, s47, s40
    v_lshrrev_b32 v3, 5, v1
    v_bfe_u32 v4, v1, 3, 2
    v_lshl_add_u32 v2, v3, 3, v4
    v_lshrrev_b32 v4, 3, v1
    v_and_b32 v4, 6, v4
    v_sub_u32 v4, v1, v4
    v_and_b32 v4, 7, v4
    v_lshlrev_b32 v4, 4, v4
    s_and_b32 s40, s39, 2
    s_add_u32 s40, s40, s39
    s_lshl_b32 s41, s45, 6
    s_add_u32 s40, s40, s41
    s_mul_i32 s40, s40, 28672
    s_lshl_b32 s41, s36, 7
    s_add_u32 s40, s40, s41
    v_mul_u32_u24 v6, 7168, v2
    v_add3_u32 v6, v6, v4, s40
    s_cmp_lg_u32 s38, 0
    s_cselect_b32 s40, 0, 1835008
    v_subrev_u32 v5, s40, v6
    s_lshl_b32 s49, s39, 14
    s_lshl_b32 s41, s38, 13
    s_add_u32 s3, s49, s41
    s_mov_b32 m0, s3
    s_waitcnt lgkmcnt(0)
    buffer_load_dwordx4 v5, s[4:7], 0 offen offset:0 nt lds
    s_mov_b32 s40, 228352
    buffer_load_dwordx4 v5, s[4:7], s40 offen offset:1024 nt lds
    s_mov_b32 s40, 456704
    buffer_load_dwordx4 v5, s[4:7], s40 offen offset:2048 nt lds
    s_mov_b32 s40, 685056
    buffer_load_dwordx4 v5, s[4:7], s40 offen offset:3072 nt lds
    s_load_dword s28, s[16:17], 0
    v_and_b32 v3, 7, v1
    v_lshlrev_b32 v7, 11, v3
    v_and_b32 v3, 8, v1
    v_lshl_add_u32 v7, v3, 3, v7
    v_and_b32 v3, 48, v1
    s_lshl2_add_u32 s40, s45, s39
    s_lshl_b32 s40, s40, 7
    v_add3_u32 v7, v7, v3, s40
    s_cmp_lg_u32 s38, 0
    s_cselect_b32 s40, 0, 512
    v_subrev_u32 v21, s40, v7
    s_lshl_b32 s58, s39, 10
    s_add_u32 s58, s58, 65536
    s_mov_b32 m0, s58
    s_nop 0
    buffer_load_dwordx4 v21, s[12:15], 0 offen offset:0 lds
    s_add_u32 m0, s58, 4096
    s_nop 0
    buffer_load_dwordx4 v7, s[12:15], 0 offen offset:0 lds
    s_add_u32 m0, s3, 4096
    s_mov_b32 s40, 917504
    buffer_load_dwordx4 v5, s[4:7], s40 offen offset:0 nt lds
    s_mov_b32 s40, 1145856
    buffer_load_dwordx4 v5, s[4:7], s40 offen offset:1024 nt lds
    s_mov_b32 s40, 1374208
    buffer_load_dwordx4 v5, s[4:7], s40 offen offset:2048 nt lds
    s_mov_b32 s40, 1602560
    buffer_load_dwordx4 v5, s[4:7], s40 offen offset:3072 nt lds
    s_cmp_lg_u32 s38, 0
    s_cbranch_scc1 L_pre
    s_add_u32 m0, s49, 8192
    s_nop 0
    buffer_load_dwordx4 v6, s[4:7], 0 offen offset:0 nt lds
    s_mov_b32 s40, 228352
    buffer_load_dwordx4 v6, s[4:7], s40 offen offset:1024 nt lds
L_pre:
    s_mov_b32 s22, 16384
    s_mov_b32 s23, 0x20000
    s_mov_b32 s52, 0x00ff00ff
    s_mov_b32 s53, 0x00ff00ff
    s_not_b64 s[54:55], s[52:53]
    v_mov_b32 v14, 0xff
    s_lshl_b32 s40, s50, 2
    s_lshr_b32 s96, 0x76243510, s40
    s_and_b32 s96, s96, 7
    s_lshl_b32 s44, s96, 5
    s_add_u32 s44, s44, s51
    s_getreg_b32 s29, hwreg(HW_REG_XCC_ID, 0, 4)
    s_lshl_b32 s67, s96, 8
    v_and_b32 v12, 31, v1
    v_lshlrev_b32 v12, 3, v12
    s_mul_i32 s66, s44, 3584
    s_add_u32 s66, s66, 921600
    v_and_b32 v3, 7, v1
    v_lshlrev_b32 v22, 4, v3
    v_and_b32 v3, 1, v1
    v_lshl_add_u32 v3, v17, 1, v3
    v_lshlrev_b32 v158, 4, v3
    v_lshlrev_b32 v18, 11, v3
    v_lshrrev_b32 v3, 4, v1
    v_lshl_add_u32 v18, v3, 1, v18
    s_lshl_b32 s40, s44, 3
    v_add_u32 v18, s40, v18
    v_lshrrev_b32 v3, 1, v1
    v_lshl_add_u32 v154, v3, 7, v158
    v_and_b32 v16, 0x37f, v11
    s_mov_b32 s10, 7340032
    s_mov_b32 s11, 0x20000
    s_sub_u32 s61, s51, 4
    s_cselect_b32 s56, 268435456, 0
    s_cselect_b32 s61, 0, s61
    s_lshl2_add_u32 s40, s61, s39
    s_lshl_b32 s40, s40, 16
    s_add_u32 s40, s40, s67
    s_add_u32 s40, s40, s56
    v_lshlrev_b32 v8, 11, v2
    v_add3_u32 v8, v8, v4, s40
    s_lshl_b32 s57, s39, 10
    v_bfe_u32 v3, v1, 2, 3
    v_lshlrev_b32 v2, 7, v3
    v_and_b32 v4, 1, v1
    v_lshl_add_u32 v2, v4, 3, v2
    v_and_b32 v3, 6, v3
    v_bfe_u32 v4, v1, 1, 1
    v_add_u32 v3, v3, v4
    v_lshl_add_u32 v4, v17, 1, v3
    v_and_b32 v4, 7, v4
    v_lshl_add_u32 v9, v4, 4, v2
    v_lshrrev_b32 v4, 5, v1
    v_lshl_add_u32 v9, v4, 15, v9
    s_cmp_gt_u32 s39, 1
    s_cselect_b32 s40, 73728, 0
    s_mov_b32 s41, 16384
    s_cselect_b32 s41, -40960, s41
    v_mul_lo_u32 v4, v4, s41
    v_add3_u32 v2, v2, v4, s40
    v_lshl_add_u32 v3, v17, 2, v3
    v_and_b32 v4, 7, v3
    v_lshl_add_u32 v10, v4, 4, v2
    v_add_u32 v3, 2, v3
    v_and_b32 v4, 7, v3
    v_lshl_add_u32 v23, v4, 4, v2
    v_add_u32 v21, 65536, v11
    s_lshl2_add_u32 s42, s36, s47
    s_lshl2_add_u32 s42, s42, s39
    s_lshl_b32 s42, s42, 10
    s_and_b32 s41, s37, 1
    s_lshl_b32 s41, s41, 7
    s_add_u32 s42, s42, s41
    s_add_u32 s42, s42, 4096
    s_lshl2_add_u32 s27, s61, s39
    s_and_b32 s40, s27, 0x78
    s_add_u32 s27, s27, s40
    s_lshl_b32 s27, s27, 10
    s_bfe_u32 s40, s29, 0x10002
    s_xor_b32 s40, s40, 0
    s_lshl_b32 s40, s40, 13
    s_add_u32 s27, s27, s40
    s_add_u32 s27, s27, 1851392
    v_mul_u32_u24 v156, 17, v22
    v_add_u32 v156, 65536, v156
    v_lshl_add_u32 v155, v17, 6, v156
    v_and_b32 v3, 56, v1
    v_add_u32 v155, v155, v3
    v_and_b32 v3, 48, v1
    v_add_u32 v156, v156, v3
    v_mov_b32 v160, 0
    v_mov_b32 v161, 0
    v_mov_b32 v162, 0
    v_mov_b32 v163, 0
    v_mov_b32 v164, 0
    v_mov_b32 v165, 0
    v_mov_b32 v166, 0
    v_mov_b32 v167, 0
    v_mov_b32 v168, 0
    v_mov_b32 v169, 0
    v_mov_b32 v170, 0
    v_mov_b32 v171, 0
    v_mov_b32 v172, 0
    v_mov_b32 v173, 0
    v_mov_b32 v174, 0
    v_mov_b32 v175, 0
    v_mov_b32 v176, 0
    v_mov_b32 v177, 0
    v_mov_b32 v178, 0
    v_mov_b32 v179, 0
    v_mov_b32 v180, 0
    v_mov_b32 v181, 0
    v_mov_b32 v182, 0
    v_mov_b32 v183, 0
    v_mov_b32 v184, 0
    v_mov_b32 v185, 0
    v_mov_b32 v186, 0
    v_mov_b32 v187, 0
    v_mov_b32 v188, 0
    v_mov_b32 v189, 0
    v_mov_b32 v190, 0
    v_mov_b32 v191, 0
    v_bfe_u32 v2, v1, 3, 1
    v_lshrrev_b32 v4, 4, v1
    v_lshl_add_u32 v13, v2, 2, v4
    v_mul_u32_u24 v13, 3584, v13
    s_lshl2_add_u32 s40, s96, s39
    s_mul_i32 s40, s40, 28672
    s_lshl_b32 s41, s61, 7
    s_add_u32 s40, s40, s41
    s_add_u32 s40, s40, s56
    s_add_u32 s40, s40, 921600
    v_add3_u32 v13, v13, v22, s40
    v_mov_b32 v32, 0
    v_mov_b32 v33, 0
    v_mov_b32 v34, 0
    v_mov_b32 v35, 0
    v_mov_b32 v36, 0
    v_mov_b32 v37, 0
    v_mov_b32 v38, 0
    v_mov_b32 v39, 0
    s_cmp_eq_u32 s56, 0
    s_cbranch_scc1 L_nors
    s_lshl_b32 s40, s51, 2
    s_lshr_b32 s46, 0x3520, s40
    s_and_b32 s46, s46, 15
    s_lshl3_add_u32 s46, s50, s46
    s_lshr_b32 s41, 0x0121, s40
    s_lshr_b32 s60, 0x0888, s40
    s_lshl2_add_u32 s40, s40, 7
    s_cmp_eq_u32 s50, 7
    s_cselect_b32 s46, s40, s46
    s_cselect_b32 s41, s60, s41
    s_cselect_b32 s61, 0, s51
    s_and_b32 s41, s41, 15
    s_lshl_b32 s40, s41, 1
    s_cmp_eq_u32 s61, 3
    s_cselect_b32 s40, 1, s40
    v_bfe_u32 v2, v1, 3, 1
    v_mul_u32_u24 v3, s40, v2
    v_lshl_add_u32 v150, v3, 13, v16
    v_mul_u32_u24 v2, s41, v2
    v_add_u32 v2, s46, v2
    v_lshrrev_b32 v3, 2, v2
    v_lshl_add_u32 v15, v3, 14, v22
    v_and_b32 v3, 3, v2
    v_lshl_add_u32 v15, v3, 11, v15
    v_lshrrev_b32 v3, 4, v1
    v_lshl_add_u32 v15, v3, 7, v15
    s_lshl_b32 s40, s39, 9
    s_add_u32 s40, s40, 1851392
    v_add_u32 v15, s40, v15
    s_lshl4_add_u32 s46, s46, s39
    s_lshl_b32 s46, s46, 10
    s_add_u32 s46, s46, 4096
    s_add_u32 s60, s46, 4096
    v_min_u32 v157, 55, v1
    s_lshl2_add_u32 s40, s51, s39
    s_mul_i32 s40, s40, 56
    v_add_lshl_u32 v157, v157, s40, 7
    buffer_load_dword v151, v15, s[16:19], 0 offen
    s_mov_b32 s40, 0x2000
    buffer_load_dword v151, v15, s[16:19], s40 offen
L_nors:
    s_waitcnt lgkmcnt(0)
    s_mul_i32 s28, s28, 1664525
    s_add_u32 s28, s28, 1013904223
    v_mov_b32 v152, s28
    v_mov_b32 v153, s29
    v_lshlrev_b32 v3, 22, v0
    s_lshl_b32 s40, s44, 3
    buffer_store_dwordx2 v[152:153], v3, s[16:19], s40 offen offset:2048 sc1
    s_bfe_u32 s32, s28, 0x70000
    s_or_b32 s92, s32, 0x80
    s_bfe_u32 s33, s28, 0x70007
    s_or_b32 s93, s33, 0x80
    s_bfe_u32 s34, s28, 0x7000e
    s_or_b32 s94, s34, 0x80
    s_bfe_u32 s35, s28, 0x70015
    s_or_b32 s95, s35, 0x80
    s_mov_b32 s64, s28
    s_mul_i32 s65, s28, 0x9e3779b1
    s_and_b32 s40, s96, 3
    s_cmp_eq_u32 s40, 1
    s_cbranch_scc0 L_nob
    s_add_u32 m0, s57, 77824
    s_mov_b32 s40, 8320
    buffer_load_dwordx4 v8, s[8:11], s40 offen offset:0 nt lds
L_nob:
    s_cmp_lg_u32 s38, 0
    s_cbranch_scc0 L_compA
    buffer_load_dword v151, v16, s[16:19], s42 offen
    s_waitcnt vmcnt(5)
    s_branch L_compB
L_compA:
    s_waitcnt vmcnt(7)
    s_add_u32 m0, s49, 8192
    s_mov_b32 s40, 456704
    buffer_load_dwordx4 v6, s[4:7], s40 offen offset:2048 nt lds
    s_mov_b32 s40, 685056
    buffer_load_dwordx4 v6, s[4:7], s40 offen offset:3072 nt lds
    s_barrier
    ds_read_b128 v[24:27], v21 offset:0
    ds_read_b64_tr_b16 v[48:49], v9 offset:0
    ds_read_b64_tr_b16 v[50:51], v9 offset:16384
    ds_read_b64_tr_b16 v[52:53], v9 offset:1024
    ds_read_b64_tr_b16 v[54:55], v9 offset:17408
    s_waitcnt lgkmcnt(2)
    v_mfma_f32_16x16x32_bf16 v[32:35], v[48:51], v[24:27], v[32:35]
    s_waitcnt lgkmcnt(0)
    v_mfma_f32_16x16x32_bf16 v[36:39], v[52:55], v[24:27], v[36:39]
    s_waitcnt vmcnt(9)
    s_add_u32 m0, s49, 12288
    s_mov_b32 s40, 917504
    buffer_load_dwordx4 v6, s[4:7], s40 offen offset:0 nt lds
    s_mov_b32 s40, 1145856
    buffer_load_dwordx4 v6, s[4:7], s40 offen offset:1024 nt lds
    s_barrier
    ds_read_b128 v[28:31], v21 offset:1024
    ds_read_b64_tr_b16 v[48:49], v9 offset:2048
    ds_read_b64_tr_b16 v[50:51], v9 offset:18432
    ds_read_b64_tr_b16 v[52:53], v9 offset:3072
    ds_read_b64_tr_b16 v[54:55], v9 offset:19456
    s_waitcnt lgkmcnt(2)
    v_mfma_f32_16x16x32_bf16 v[32:35], v[48:51], v[28:31], v[32:35]
    s_waitcnt lgkmcnt(0)
    v_mfma_f32_16x16x32_bf16 v[36:39], v[52:55], v[28:31], v[36:39]
    s_waitcnt vmcnt(8)
    s_mov_b32 s40, 1374208
    buffer_load_dwordx4 v6, s[4:7], s40 offen offset:2048 nt lds
    s_mov_b32 s40, 1602560
    buffer_load_dwordx4 v6, s[4:7], s40 offen offset:3072 nt lds
    s_barrier
    ds_read_b128 v[24:27], v21 offset:2048
    ds_read_b64_tr_b16 v[48:49], v9 offset:4096
    ds_read_b64_tr_b16 v[50:51], v9 offset:20480
    ds_read_b64_tr_b16 v[52:53], v9 offset:5120
    ds_read_b64_tr_b16 v[54:55], v9 offset:21504
    s_waitcnt lgkmcnt(2)
    v_mfma_f32_16x16x32_bf16 v[32:35], v[48:51], v[24:27], v[32:35]
    s_waitcnt lgkmcnt(0)
    v_mfma_f32_16x16x32_bf16 v[36:39], v[52:55], v[24:27], v[36:39]
    s_waitcnt vmcnt(8)
    buffer_load_dword v151, v16, s[16:19], s42 offen
    s_barrier
    ds_read_b128 v[28:31], v21 offset:3072
    ds_read_b64_tr_b16 v[48:49], v9 offset:6144
    ds_read_b64_tr_b16 v[50:51], v9 offset:22528
    ds_read_b64_tr_b16 v[52:53], v9 offset:7168
    ds_read_b64_tr_b16 v[54:55], v9 offset:23552
    s_waitcnt lgkmcnt(2)
    v_mfma_f32_16x16x32_bf16 v[32:35], v[48:51], v[28:31], v[32:35]
    s_waitcnt lgkmcnt(0)
    v_mfma_f32_16x16x32_bf16 v[36:39], v[52:55], v[28:31], v[36:39]
L_compB:
    s_waitcnt vmcnt(7)
    s_add_u32 m0, s57, 73728
    s_mov_b32 s40, 128
    buffer_load_dwordx4 v8, s[8:11], s40 offen offset:0 nt lds
    s_barrier
    ds_read_b128 v[24:27], v21 offset:4096
    ds_read_b64_tr_b16 v[48:49], v9 offset:8192
    ds_read_b64_tr_b16 v[50:51], v9 offset:24576
    ds_read_b64_tr_b16 v[52:53], v9 offset:9216
    ds_read_b64_tr_b16 v[54:55], v9 offset:25600
    s_waitcnt lgkmcnt(2)
    v_mfma_f32_16x16x32_bf16 v[32:35], v[48:51], v[24:27], v[32:35]
    s_waitcnt lgkmcnt(0)
    v_mfma_f32_16x16x32_bf16 v[36:39], v[52:55], v[24:27], v[36:39]
    s_waitcnt vmcnt(6)
    s_barrier
    ds_read_b128 v[28:31], v21 offset:5120
    ds_read_b64_tr_b16 v[48:49], v9 offset:10240
    ds_read_b64_tr_b16 v[50:51], v9 offset:26624
    ds_read_b64_tr_b16 v[52:53], v9 offset:11264
    ds_read_b64_tr_b16 v[54:55], v9 offset:27648
    s_waitcnt lgkmcnt(2)
    v_mfma_f32_16x16x32_bf16 v[32:35], v[48:51], v[28:31], v[32:35]
    s_waitcnt lgkmcnt(0)
    v_mfma_f32_16x16x32_bf16 v[36:39], v[52:55], v[28:31], v[36:39]
    s_waitcnt vmcnt(4)
    s_barrier
    ds_read_b128 v[24:27], v21 offset:6144
    ds_read_b64_tr_b16 v[48:49], v9 offset:12288
    ds_read_b64_tr_b16 v[50:51], v9 offset:28672
    ds_read_b64_tr_b16 v[52:53], v9 offset:13312
    ds_read_b64_tr_b16 v[54:55], v9 offset:29696
    s_waitcnt lgkmcnt(2)
    v_mfma_f32_16x16x32_bf16 v[32:35], v[48:51], v[24:27], v[32:35]
    s_waitcnt lgkmcnt(0)
    v_mfma_f32_16x16x32_bf16 v[36:39], v[52:55], v[24:27], v[36:39]
    s_waitcnt vmcnt(3)
    s_barrier
    ds_read_b128 v[28:31], v21 offset:7168
    ds_read_b64_tr_b16 v[48:49], v9 offset:14336
    ds_read_b64_tr_b16 v[50:51], v9 offset:30720
    s_waitcnt lgkmcnt(0)
    v_mfma_f32_16x16x32_bf16 v[32:35], v[48:51], v[28:31], v[32:35]
    s_waitcnt vmcnt(2)
    s_barrier
    ds_read_b64_tr_b16 v[48:49], v9 offset:15360
    ds_read_b64_tr_b16 v[50:51], v9 offset:31744
    s_waitcnt lgkmcnt(0)
    v_mfma_f32_16x16x32_bf16 v[36:39], v[48:51], v[28:31], v[36:39]
    s_mov_b32 s43, 1048576
    s_nop 6
    v_add_f32_dpp v140, v36, v32 row_ror:8 row_mask:0xf bank_mask:0xf
    v_add_f32_dpp v141, v37, v33 row_ror:8 row_mask:0xf bank_mask:0xf
    v_add_f32_dpp v142, v38, v34 row_ror:8 row_mask:0xf bank_mask:0xf
    v_add_f32_dpp v143, v39, v35 row_ror:8 row_mask:0xf bank_mask:0xf
    v_bfi_b32 v140, v14, s92, v140
    v_bfi_b32 v141, v14, s93, v141
    v_bfi_b32 v142, v14, s94, v142
    v_bfi_b32 v143, v14, s95, v143
    s_mov_b64 exec, s[52:53]
    buffer_store_dwordx4 v[140:143], v11, s[16:19], s42 offen
    s_mov_b64 exec, -1
    s_cmp_lg_u32 s56, 0
    s_cbranch_scc1 L_reduce
    s_barrier
    s_and_b32 s40, s96, 3
    s_cmp_eq_u32 s40, 1
    s_cbranch_scc1 L_skipb
    s_add_u32 m0, s57, 77824
    s_mov_b32 s40, 8320
    buffer_load_dwordx4 v8, s[8:11], s40 offen offset:0 nt lds
L_skipb:
    s_add_u32 m0, s57, 32768
    s_mov_b32 s40, 32896
    buffer_load_dwordx4 v8, s[8:11], s40 offen offset:0 nt lds
    s_add_u32 m0, s57, 36864
    s_mov_b32 s40, 41088
    buffer_load_dwordx4 v8, s[8:11], s40 offen offset:0 nt lds
    s_mov_b32 m0, s57
    s_nop 0
    buffer_load_dwordx4 v8, s[8:11], 0 offen offset:0 nt lds
    s_add_u32 m0, s57, 4096
    s_mov_b32 s40, 8192
    buffer_load_dwordx4 v8, s[8:11], s40 offen offset:0 nt lds
    s_add_u32 m0, s57, 16384
    s_mov_b32 s40, 32768
    buffer_load_dwordx4 v8, s[8:11], s40 offen offset:0 nt lds
    s_add_u32 m0, s57, 20480
    s_mov_b32 s40, 40960
    buffer_load_dwordx4 v8, s[8:11], s40 offen offset:0 nt lds
    s_waitcnt vmcnt(5)
    s_load_dwordx8 s[72:79], s[16:17], 512
    buffer_load_dwordx2 v[152:153], v12, s[16:19], s67 offen offset:2048 sc1
    buffer_load_ushort v19, v18, s[12:15], 0 offen
    buffer_load_dwordx4 v[192:195], v158, s[16:19], 0 offen offset:1024 sc1
    s_mov_b32 s41, 0
    s_waitcnt lgkmcnt(0)
    s_cmp_eq_u32 s72, s28
    s_cselect_b32 s40, s73, 0
    s_add_i32 s41, s41, s40
    s_cmp_eq_u32 s74, s28
    s_cselect_b32 s40, s75, 0
    s_add_i32 s41, s41, s40
    s_cmp_eq_u32 s76, s28
    s_cselect_b32 s40, s77, 0
    s_add_i32 s41, s41, s40
    s_cmp_eq_u32 s78, s28
    s_cselect_b32 s40, s79, 0
    s_add_i32 s41, s41, s40
    s_cmp_gt_i32 s41, 0
    s_cselect_b32 s40, 0x2000, 0
    s_xor_b32 s27, s27, s40
    s_waitcnt vmcnt(6)
    buffer_load_dwordx4 v[96:99], v11, s[16:19], s27 offen sc1
    s_waitcnt vmcnt(4)
    s_barrier
    ds_read_b64_tr_b16 v[64:65], v10 offset:0
    ds_read_b64_tr_b16 v[66:67], v10 offset:4096
    ds_read_b64_tr_b16 v[68:69], v23 offset:0
    ds_read_b64_tr_b16 v[70:71], v23 offset:4096
    ds_read_b64_tr_b16 v[72:73], v10 offset:1024
    ds_read_b64_tr_b16 v[74:75], v10 offset:5120
    ds_read_b64_tr_b16 v[76:77], v23 offset:1024
    ds_read_b64_tr_b16 v[78:79], v23 offset:5120
    ds_read_b64_tr_b16 v[80:81], v10 offset:2048
    ds_read_b64_tr_b16 v[82:83], v10 offset:6144
    ds_read_b64_tr_b16 v[84:85], v23 offset:2048
    ds_read_b64_tr_b16 v[86:87], v23 offset:6144
    ds_read_b64_tr_b16 v[88:89], v10 offset:3072
    ds_read_b64_tr_b16 v[90:91], v10 offset:7168
    ds_read_b64_tr_b16 v[92:93], v23 offset:3072
    ds_read_b64_tr_b16 v[94:95], v23 offset:7168
    s_waitcnt vmcnt(1)
    v_cmp_eq_u64 s[62:63], s[28:29], v[152:153]
    s_cmp_eq_u64 s[62:63], -1
    s_cbranch_scc1 L_tc1
    s_mov_b64 exec, s[52:53]
    buffer_store_dwordx4 v[140:143], v11, s[16:19], s42 offen sc1
    s_mov_b64 exec, -1
L_tc1:
    s_branch L_pollhw
L_pollh:
    s_sub_u32 s43, s43, 1
    s_cbranch_scc1 L_pollh_done
    buffer_load_dwordx4 v[96:99], v11, s[16:19], s27 offen sc1
L_pollhw:
    s_waitcnt vmcnt(0)
    v_cmp_ne_u64 vcc, s[64:65], v[98:99]
    s_cbranch_vccnz L_pollh
L_pollh_done:
    ds_write_b64 v155, v[96:97]
    s_mov_b64 exec, s[52:53]
    s_waitcnt lgkmcnt(0)
    s_barrier
    ds_read_b128 v[160:163], v156 offset:0
    ds_read_b128 v[164:167], v156 offset:64
    ds_read_b128 v[168:171], v156 offset:128
    ds_read_b128 v[172:175], v156 offset:192
    s_mov_b64 exec, s[54:55]
    ds_read_b128 v[176:179], v156 offset:0
    ds_read_b128 v[180:183], v156 offset:64
    ds_read_b128 v[184:187], v156 offset:128
    ds_read_b128 v[188:191], v156 offset:192
    s_mov_b64 exec, -1
    s_waitcnt lgkmcnt(7)
    v_mfma_f32_16x16x32_bf16 v[32:35], v[64:67], v[160:163], 0
    s_waitcnt lgkmcnt(6)
    v_mfma_f32_16x16x32_bf16 v[32:35], v[72:75], v[164:167], v[32:35]
    s_waitcnt lgkmcnt(5)
    v_mfma_f32_16x16x32_bf16 v[32:35], v[80:83], v[168:171], v[32:35]
    s_waitcnt lgkmcnt(4)
    v_mfma_f32_16x16x32_bf16 v[32:35], v[88:91], v[172:175], v[32:35]
    s_waitcnt lgkmcnt(3)
    v_mfma_f32_16x16x32_bf16 v[32:35], v[68:71], v[176:179], v[32:35]
    s_waitcnt lgkmcnt(2)
    v_mfma_f32_16x16x32_bf16 v[32:35], v[76:79], v[180:183], v[32:35]
    s_waitcnt lgkmcnt(1)
    v_mfma_f32_16x16x32_bf16 v[32:35], v[84:87], v[184:187], v[32:35]
    s_waitcnt lgkmcnt(0)
    v_mfma_f32_16x16x32_bf16 v[32:35], v[92:95], v[188:191], v[32:35]
    s_cmp_eq_u64 s[62:63], -1
    s_nop 6
    v_bfi_b32 v128, v14, s92, v32
    v_bfi_b32 v129, v14, s93, v33
    v_bfi_b32 v130, v14, s94, v34
    v_bfi_b32 v131, v14, s95, v35
    s_cbranch_scc0 L_far
    buffer_store_dwordx4 v[128:131], v13, s[16:19], 0 offen
L_fin:
    s_mov_b32 s43, 1048576
    s_mov_b32 exec_hi, 0x00ffffff
    buffer_load_dwordx4 v[100:103], v154, s[16:19], s66 offen sc1
    s_mov_b32 exec_hi, -1
L_rchk:
    v_xor_b32 v192, s32, v192
    v_xor_b32 v193, s33, v193
    v_xor_b32 v194, s34, v194
    v_xor_b32 v195, s35, v195
    v_or_b32 v132, v192, v193
    v_or3_b32 v132, v132, v194, v195
    v_and_b32 v132, 0x7f, v132
    v_cmp_ne_u32 vcc, 0, v132
    s_cbranch_vccnz L_rpoll
    v_mov_b32 v96, 0
    v_mov_b32 v97, 0
    v_mov_b32 v98, 0
    v_mov_b32 v99, 0
    v_and_b32 v20, 0xffff0000, v192
    v_lshlrev_b32 v19, 16, v19
    v_fma_f32 v19, v19, 0, v19
    s_mov_b32 exec_hi, 0x00ffffff
    s_branch L_poll2w
L_poll2:
    s_sub_u32 s43, s43, 1
    s_cbranch_scc1 L_poll2_done
    buffer_load_dwordx4 v[100:103], v154, s[16:19], s66 offen sc1
L_poll2w:
    s_waitcnt vmcnt(0)
    v_xor_b32 v96, s32, v100
    v_xor_b32 v97, s33, v101
    v_xor_b32 v98, s34, v102
    v_xor_b32 v99, s35, v103
    v_or_b32 v132, v96, v97
    v_or3_b32 v132, v132, v98, v99
    v_and_b32 v132, 0x7f, v132
    v_cmp_ne_u32 vcc, 0, v132
    s_cbranch_vccnz L_poll2
L_poll2_done:
    s_mov_b32 exec_hi, -1
    v_permlane32_swap_b32 v96, v98
    v_permlane32_swap_b32 v97, v99
    v_add_f32 v96, v96, v98
    v_add_f32 v97, v97, v99
    s_nop 1
    v_permlane16_swap_b32 v96, v97
    v_add_f32 v96, v96, v97
    s_nop 1
    v_add_f32_dpp v96, v96, v96 row_ror:8 row_mask:0xf bank_mask:0xf
    s_nop 1
    v_add_f32_dpp v96, v96, v96 row_ror:4 row_mask:0xf bank_mask:0xf
    s_nop 1
    v_add_f32_dpp v96, v96, v96 row_ror:2 row_mask:0xf bank_mask:0xf
    v_cvt_pk_bf16_f32 v96, v96, v96
    v_lshlrev_b32 v96, 16, v96
    v_mul_f32 v96, v96, v20
    v_cvt_pk_bf16_f32 v96, v96, v96
    v_lshlrev_b32 v96, 16, v96
    v_add_f32 v96, v96, v19
    v_cvt_pk_bf16_f32 v96, v96, v96
    s_mov_b32 exec_lo, 0x00030003
    s_mov_b32 exec_hi, 0x00030003
    buffer_store_short v96, v18, s[20:23], 0 offen
    s_or_b32 s40, s44, s39
    s_cbranch_scc1 L_fin_done
    s_mov_b64 exec, 1
    v_mov_b32 v3, s28
    buffer_store_dword v3, v11, s[16:19], 0 offen
L_fin_done:
L_end:
    s_endpgm
L_far:
    buffer_store_dwordx4 v[128:131], v13, s[16:19], 0 offen sc1
    s_branch L_fin
L_rpoll:
    s_sub_u32 s43, s43, 1
    s_cbranch_scc1 L_fin_done
    buffer_load_dwordx4 v[192:195], v158, s[16:19], 0 offen offset:1024 sc1
    s_waitcnt vmcnt(0)
    s_branch L_rchk
L_reduce:
    s_bfe_u32 s98, s29, 0x10002
    s_xor_b32 s98, s98, 0
    s_lshl_b32 s98, s98, 13
    s_xor_b32 s97, s98, 0x2000
    v_mov_b32 v148, s64
    v_mov_b32 v149, s65
    s_mov_b32 s43, 1048576
    s_mov_b32 s40, 0xbfb8aa3b
    s_mov_b32 s41, 0xffff0000
L_poll1:
    s_cmp_lg_u32 s43, 1048536
    s_cbranch_scc1 L_poll1b
    s_mov_b64 exec, s[52:53]
    buffer_store_dwordx4 v[140:143], v11, s[16:19], s42 offen sc1
    s_mov_b64 exec, -1
L_poll1b:
    s_sub_u32 s43, s43, 1
    s_cbranch_scc1 L_poll1_done
    buffer_load_dwordx4 v[96:99], v150, s[16:19], s46 offen offset:0 sc1
    buffer_load_dwordx4 v[100:103], v150, s[16:19], s60 offen offset:0 sc1
    buffer_load_dwordx4 v[104:107], v150, s[16:19], s46 offen offset:128 sc1
    buffer_load_dwordx4 v[108:111], v150, s[16:19], s60 offen offset:128 sc1
    s_waitcnt vmcnt(3)
    v_xor_b32 v96, s32, v96
    v_xor_b32 v97, s33, v97
    v_xor_b32 v98, s34, v98
    v_xor_b32 v99, s35, v99
    v_or_b32 v132, v96, v97
    v_or3_b32 v132, v132, v98, v99
    s_waitcnt vmcnt(2)
    v_xor_b32 v100, s32, v100
    v_xor_b32 v101, s33, v101
    v_xor_b32 v102, s34, v102
    v_xor_b32 v103, s35, v103
    v_or3_b32 v132, v132, v100, v101
    v_or3_b32 v132, v132, v102, v103
    v_pk_add_f32 v[96:97], v[96:97], v[100:101]
    v_pk_add_f32 v[98:99], v[98:99], v[102:103]
    s_waitcnt vmcnt(1)
    v_xor_b32 v104, s32, v104
    v_xor_b32 v105, s33, v105
    v_xor_b32 v106, s34, v106
    v_xor_b32 v107, s35, v107
    v_or3_b32 v132, v132, v104, v105
    v_or3_b32 v132, v132, v106, v107
    s_waitcnt vmcnt(0)
    v_xor_b32 v108, s32, v108
    v_xor_b32 v109, s33, v109
    v_xor_b32 v110, s34, v110
    v_xor_b32 v111, s35, v111
    v_or3_b32 v132, v132, v108, v109
    v_or3_b32 v132, v132, v110, v111
    v_and_b32 v132, 0x7f, v132
    v_cmp_ne_u32 vcc, 0, v132
    s_cbranch_vccnz L_poll1
L_poll1_done:
    v_pk_add_f32 v[104:105], v[104:105], v[108:109]
    v_pk_add_f32 v[106:107], v[106:107], v[110:111]
    s_cmp_lg_u32 s61, 3
    s_cbranch_scc1 L_act
    v_add_f32_dpp v96, v96, v96 row_ror:8 row_mask:0xf bank_mask:0xf
    v_add_f32_dpp v97, v97, v97 row_ror:8 row_mask:0xf bank_mask:0xf
    v_add_f32_dpp v98, v98, v98 row_ror:8 row_mask:0xf bank_mask:0xf
    v_add_f32_dpp v99, v99, v99 row_ror:8 row_mask:0xf bank_mask:0xf
    v_add_f32_dpp v104, v104, v104 row_ror:8 row_mask:0xf bank_mask:0xf
    v_add_f32_dpp v105, v105, v105 row_ror:8 row_mask:0xf bank_mask:0xf
    v_add_f32_dpp v106, v106, v106 row_ror:8 row_mask:0xf bank_mask:0xf
    v_add_f32_dpp v107, v107, v107 row_ror:8 row_mask:0xf bank_mask:0xf
L_act:
    v_cvt_pk_bf16_f32 v128, v96, v97
    v_cvt_pk_bf16_f32 v129, v98, v99
    v_lshlrev_b32 v96, 16, v128
    v_and_b32 v97, s41, v128
    v_lshlrev_b32 v98, 16, v129
    v_and_b32 v99, s41, v129
    v_mul_f32 v128, s40, v96
    v_mul_f32 v129, s40, v97
    v_mul_f32 v130, s40, v98
    v_mul_f32 v131, s40, v99
    v_exp_f32 v128, v128
    v_exp_f32 v129, v129
    v_exp_f32 v130, v130
    v_exp_f32 v131, v131
    v_cvt_pk_bf16_f32 v134, v104, v105
    v_cvt_pk_bf16_f32 v135, v106, v107
    v_pk_add_f32 v[128:129], v[128:129], 1.0 op_sel_hi:[1,0]
    v_pk_add_f32 v[130:131], v[130:131], 1.0 op_sel_hi:[1,0]
    v_rcp_f32 v128, v128
    v_rcp_f32 v129, v129
    v_rcp_f32 v130, v130
    v_rcp_f32 v131, v131
    v_lshlrev_b32 v104, 16, v134
    v_and_b32 v105, s41, v134
    v_lshlrev_b32 v106, 16, v135
    v_and_b32 v107, s41, v135
    v_pk_mul_f32 v[128:129], v[128:129], v[96:97]
    v_pk_mul_f32 v[130:131], v[130:131], v[98:99]
    v_cvt_pk_bf16_f32 v132, v128, v129
    v_cvt_pk_bf16_f32 v133, v130, v131
    v_lshlrev_b32 v128, 16, v132
    v_and_b32 v129, s41, v132
    v_lshlrev_b32 v130, 16, v133
    v_and_b32 v131, s41, v133
    v_pk_mul_f32 v[128:129], v[128:129], v[104:105]
    v_pk_mul_f32 v[130:131], v[130:131], v[106:107]
    v_cvt_pk_bf16_f32 v146, v128, v129
    v_cvt_pk_bf16_f32 v147, v130, v131
    buffer_store_dwordx4 v[146:149], v15, s[16:19], s97 offen sc1
    buffer_store_dwordx4 v[146:149], v15, s[16:19], s98 offen sc1
    s_barrier
    s_mul_i32 s40, s96, 114688
    s_add_u32 s40, s40, 921600
    buffer_load_dword v151, v157, s[16:19], s40 offen
    buffer_load_dwordx2 v[152:153], v12, s[16:19], s67 offen offset:2048 sc1
    buffer_load_ushort v19, v18, s[12:15], 0 offen
    buffer_load_dwordx4 v[192:195], v158, s[16:19], 0 offen offset:1024 sc1
    s_waitcnt vmcnt(0)
    v_cmp_eq_u64 s[62:63], s[28:29], v[152:153]
    s_cmp_eq_u64 s[62:63], -1
    s_cbranch_scc1 L_tc2
    s_mov_b64 exec, s[52:53]
    buffer_store_dwordx4 v[140:143], v11, s[16:19], s42 offen sc1
    s_mov_b64 exec, -1
L_tc2:
    s_branch L_fin
L_router:
    s_load_dwordx2 s[24:25], s[0:1], 8
    s_mov_b32 s26, 2048
    s_mov_b32 s27, 0x20000
    s_mov_b32 s22, 16384
    s_mov_b32 s23, 0x20000
    s_mov_b32 s52, 0x00ff00ff
    s_mov_b32 s53, 0x00ff00ff
    s_not_b64 s[54:55], s[52:53]
    v_mov_b32 v14, 0xff
    s_lshl_b32 s40, s50, 2
    s_lshr_b32 s96, 0x76243510, s40
    s_and_b32 s96, s96, 7
    s_lshl_b32 s44, s96, 5
    s_add_u32 s44, s44, s51
    s_getreg_b32 s29, hwreg(HW_REG_XCC_ID, 0, 4)
    s_lshl_b32 s67, s96, 8
    v_and_b32 v12, 31, v1
    v_lshlrev_b32 v12, 3, v12
    s_mul_i32 s66, s44, 3584
    s_add_u32 s66, s66, 921600
    v_and_b32 v3, 7, v1
    v_lshlrev_b32 v22, 4, v3
    v_and_b32 v3, 1, v1
    v_lshl_add_u32 v3, v17, 1, v3
    v_lshlrev_b32 v158, 4, v3
    v_lshlrev_b32 v18, 11, v3
    v_lshrrev_b32 v3, 4, v1
    v_lshl_add_u32 v18, v3, 1, v18
    s_lshl_b32 s40, s44, 3
    v_add_u32 v18, s40, v18
    v_lshrrev_b32 v3, 1, v1
    v_lshl_add_u32 v154, v3, 7, v158
    v_and_b32 v16, 0x37f, v11
    s_lshl1_add_u32 s47, s51, s39
    s_and_b32 s47, s47, 7
    s_lshl_b32 s41, s47, 11
    s_mov_b32 s42, 126976
    s_waitcnt lgkmcnt(0)
    s_load_dword s28, s[16:17], 0
    s_cmp_lg_u32 s39, 3
    s_cbranch_scc1 L_noprobe
    s_lshl_b32 s74, s51, 10
    s_add_u32 s74, s74, 258048
    s_add_u32 s75, s74, 4096
    v_mov_b32 v100, 0
    v_mov_b32 v101, 0
    v_mov_b32 v102, 0
    v_mov_b32 v103, 0
    buffer_store_dwordx4 v[100:103], v11, s[16:19], s74 offen sc1
    buffer_store_dwordx4 v[100:103], v11, s[16:19], s75 offen sc1
L_noprobe:
    buffer_load_dwordx4 v[64:67], v11, s[12:15], s41 offen
    buffer_load_dwordx4 v[68:71], v11, s[12:15], s41 offen offset:1024
    buffer_load_dwordx4 v[72:75], v11, s[24:27], 0 offen
    buffer_load_dwordx4 v[76:79], v11, s[24:27], 0 offen offset:1024
    v_mov_b32 v20, 0
    s_lshl_b32 s40, s51, 2
    s_lshr_b32 s46, 0x3520, s40
    s_and_b32 s46, s46, 15
    s_lshl3_add_u32 s46, s50, s46
    s_lshr_b32 s41, 0x0121, s40
    s_lshr_b32 s60, 0x0888, s40
    s_lshl2_add_u32 s40, s40, 7
    s_cmp_eq_u32 s50, 7
    s_cselect_b32 s46, s40, s46
    s_cselect_b32 s41, s60, s41
    s_cselect_b32 s61, 0, s51
    s_and_b32 s41, s41, 15
    s_lshl_b32 s40, s41, 1
    s_cmp_eq_u32 s61, 3
    s_cselect_b32 s40, 1, s40
    v_bfe_u32 v2, v1, 3, 1
    v_mul_u32_u24 v3, s40, v2
    v_lshl_add_u32 v150, v3, 13, v16
    v_mul_u32_u24 v2, s41, v2
    v_add_u32 v2, s46, v2
    v_lshrrev_b32 v3, 2, v2
    v_lshl_add_u32 v15, v3, 14, v22
    v_and_b32 v3, 3, v2
    v_lshl_add_u32 v15, v3, 11, v15
    v_lshrrev_b32 v3, 4, v1
    v_lshl_add_u32 v15, v3, 7, v15
    s_lshl_b32 s40, s39, 9
    s_add_u32 s40, s40, 1851392
    v_add_u32 v15, s40, v15
    s_lshl4_add_u32 s46, s46, s39
    s_lshl_b32 s46, s46, 10
    s_add_u32 s46, s46, 4096
    s_add_u32 s60, s46, 4096
    v_min_u32 v157, 55, v1
    s_lshl2_add_u32 s40, s51, s39
    s_mul_i32 s40, s40, 56
    v_add_lshl_u32 v157, v157, s40, 7
    s_waitcnt lgkmcnt(0)
    s_mul_i32 s28, s28, 1664525
    s_add_u32 s28, s28, 1013904223
    v_mov_b32 v152, s28
    v_mov_b32 v153, s29
    v_lshlrev_b32 v3, 22, v0
    s_lshl_b32 s40, s44, 3
    buffer_store_dwordx2 v[152:153], v3, s[16:19], s40 offen offset:2048 sc1
    s_bfe_u32 s32, s28, 0x70000
    s_or_b32 s92, s32, 0x80
    s_bfe_u32 s33, s28, 0x70007
    s_or_b32 s93, s33, 0x80
    s_bfe_u32 s34, s28, 0x7000e
    s_or_b32 s94, s34, 0x80
    s_bfe_u32 s35, s28, 0x70015
    s_or_b32 s95, s35, 0x80
    s_mov_b32 s64, s28
    s_mul_i32 s65, s28, 0x9e3779b1
    s_waitcnt vmcnt(1)
    s_barrier
    s_cmp_lg_u32 s39, 3
    s_cbranch_scc1 L_noprobe2
    v_lshlrev_b32 v4, 7, v1
    s_mov_b64 exec, 15
    s_and_b32 s72, s51, 1
    s_cselect_b32 s76, s75, s74
    s_cselect_b32 s77, s74, s75
    s_bfe_u32 s73, s29, 0x10002
    s_xor_b32 s72, s72, s73
    s_mov_b32 s78, 0
    v_mov_b32 v97, 1
    buffer_load_dword v96, v4, s[16:19], s76 offen offset:0 sc1
    buffer_load_dword v97, v4, s[16:19], s77 offen offset:0 sc1
    s_waitcnt vmcnt(1)
    v_cmp_ne_u32 vcc, 0, v97
    s_cmp_lg_u64 vcc, 0
    s_cselect_b32 s73, 1, 0
    s_waitcnt vmcnt(0)
    s_xor_b32 s73, s73, s72
    s_lshl1_add_u32 s78, s73, s78
    s_sub_u32 s78, s78, 1
    v_mov_b32 v98, s28
    v_mov_b32 v99, s78
    s_lshl_b32 s74, s51, 3
    s_mov_b64 exec, 1
    buffer_store_dwordx2 v[98:99], v11, s[16:19], s74 offen offset:512 sc1
    s_mov_b64 exec, -1
L_noprobe2:
    s_cmp_gt_u32 s39, 1
    s_cbranch_scc1 L_rdone
    s_waitcnt vmcnt(0)
    v_dot2c_f32_bf16 v20, v64, v72
    v_dot2c_f32_bf16 v20, v65, v73
    v_dot2c_f32_bf16 v20, v66, v74
    v_dot2c_f32_bf16 v20, v67, v75
    v_dot2c_f32_bf16 v20, v68, v76
    v_dot2c_f32_bf16 v20, v69, v77
    v_dot2c_f32_bf16 v20, v70, v78
    v_dot2c_f32_bf16 v20, v71, v79
    s_nop 2
    v_add_f32_dpp v20, v20, v20 row_ror:1 row_mask:0xf bank_mask:0xf
    s_nop 1
    v_add_f32_dpp v20, v20, v20 row_ror:2 row_mask:0xf bank_mask:0xf
    s_nop 1
    v_add_f32_dpp v20, v20, v20 row_ror:4 row_mask:0xf bank_mask:0xf
    s_nop 1
    v_add_f32_dpp v20, v20, v20 row_ror:8 row_mask:0xf bank_mask:0xf
    s_nop 1
    v_mov_b32 v3, v20
    s_nop 1
    v_permlane16_swap_b32 v20, v3
    v_add_f32 v20, v20, v3
    v_mov_b32 v3, v20
    s_nop 1
    v_permlane32_swap_b32 v20, v3
    v_add_f32 v20, v20, v3
    v_cvt_pk_bf16_f32 v20, v20, v20
    v_lshlrev_b32 v20, 16, v20
    v_mul_f32 v20, 0xbfb8aa3b, v20
    v_exp_f32 v20, v20
    s_nop 0
    v_add_f32 v20, 1.0, v20
    v_rcp_f32 v20, v20
    s_nop 0
    v_cvt_pk_bf16_f32 v20, v20, v20
    v_bfi_b32 v128, v14, s92, v20
    v_mov_b32 v129, s33
    v_mov_b32 v130, s34
    v_mov_b32 v131, s35
    s_lshl_b32 s40, s47, 4
    s_mov_b64 exec, 1
    buffer_store_dwordx4 v[128:131], v11, s[16:19], s40 offen offset:1024 sc1
    s_mov_b64 exec, -1
L_rdone:
    s_barrier
    buffer_load_dword v151, v15, s[16:19], 0 offen
    s_mov_b32 s40, 0x2000
    buffer_load_dword v151, v15, s[16:19], s40 offen
    s_branch L_reduce
L_codeend:
.section .rodata,"a"
.p2align 6
.amdhsa_kernel standalone__moe_arch_mod__decode_kernel
  .amdhsa_next_free_vgpr 196
  .amdhsa_next_free_sgpr 100
  .amdhsa_accum_offset 196
  .amdhsa_group_segment_fixed_size 0
  .amdhsa_kernarg_size 64
  .amdhsa_user_sgpr_count 2
  .amdhsa_user_sgpr_kernarg_segment_ptr 1
  .amdhsa_system_sgpr_workgroup_id_x 1
  .amdhsa_float_denorm_mode_32 3
.end_amdhsa_kernel
```
